```python
import torch

def _softmax(x, axis=-1):
    return torch.softmax(x, dim=axis)
def _gelu(x):
    return torch.nn.functional.gelu(x, approximate="tanh")
def _silu(x):
    return torch.nn.functional.silu(x)
def _sigmoid(x):
    return torch.sigmoid(x)
def _layernorm(x, axis=-1, eps=1e-5):
    m = x.mean(dim=axis, keepdim=True)
    v = x.var(dim=axis, keepdim=True, unbiased=False)
    return (x - m) / torch.sqrt(v + eps)
def _scatter_add(tgt, idx, src, axis=0):
    return tgt.clone().index_add_(axis, idx, src)
def _segment_sum(src, seg, n):
    out = torch.zeros((n,) + src.shape[1:], dtype=src.dtype)
    return out.index_add_(0, seg, src)
def _pad(x, pw):
    flat = tuple(v for pair in reversed(pw) for v in pair)
    return torch.nn.functional.pad(x, flat)

kernel_name = 'standalone__sliding_local_fixed_window__prompt'

def setup_inputs():

    _w = (lambda a: (lambda t: t.to(torch.bfloat16) if t.is_floating_point() else t)(torch.as_tensor(a)))
    B, H, S, D = 1, 32, 2048, 192
    return {
        "q": _w((lambda *s: torch.randn(*s, dtype=torch.bfloat16) * 0.8)(B, H, S, D)),
        "k": _w((lambda *s: torch.randn(*s, dtype=torch.bfloat16) * 0.8)(B, H, S, D)),
        "v": _w((lambda *s: torch.randn(*s, dtype=torch.bfloat16) * 0.05)(B, H, S, D)),
    }

def reference(q, k, v):
    B, H, S, D = q.shape
    w = 32
    pos = torch.arange(S)
    rel = pos[:, None] - pos[None, :]
    mask = (rel >= 0) & (rel < w)
    scores = torch.einsum("bhqd,bhkd->bhqk", q, k) * (D ** -0.5)
    scores = torch.where(mask[None, None], scores, (lambda x, dt: x.to(dt))(torch.as_tensor(-1e9), q.dtype))
    p = _softmax(scores, axis=-1)
    return torch.einsum("bhqk,bhkd->bhqd", p, v)
```

```asm
; @launch grid=(256,1,1) block=(320,1,1) lds=161024
.amdgcn_target "amdgcn-amd-amdhsa--gfx950"
.text
.globl standalone__sliding_local_fixed_window__prompt_kernel
.p2align 8
.type standalone__sliding_local_fixed_window__prompt_kernel,@function
standalone__sliding_local_fixed_window__prompt_kernel:
  s_load_dwordx2 s[16:17], s[0:1], 8
  s_load_dwordx2 s[12:13], s[0:1], 0
  s_load_dwordx2 s[20:21], s[0:1], 16
  s_load_dwordx2 s[24:25], s[0:1], 24
  v_lshrrev_b32 v26, 6, v0
  v_lshlrev_b32 v8, 2, v0
  s_cmp_ge_u32 s2, 256
  v_readfirstlane_b32 s28, v26
  s_cbranch_scc1 L_end
  v_and_b32 v0, 63, v0
  v_lshrrev_b32 v28, 3, v0
  v_lshlrev_b32 v7, 4, v0
  v_mul_u32_u24 v28, 11, v28
  v_lshrrev_b32 v29, 1, v28
  v_and_b32 v29, 0x70, v29
  v_xor_b32 v1, v29, v7
  v_add_u32 v4, 3072, v1
  v_add_u32 v28, 88, v28
  v_lshrrev_b32 v29, 1, v28
  v_and_b32 v29, 0x70, v29
  v_xor_b32 v2, v29, v7
  v_add_u32 v5, 3072, v2
  v_add_u32 v28, 88, v28
  v_lshrrev_b32 v29, 1, v28
  v_and_b32 v29, 0x70, v29
  v_xor_b32 v3, v29, v7
  v_add_u32 v6, 3072, v3
  s_and_b32 s46, s2, 7
  s_lshl_b32 s46, s46, 5
  s_lshr_b32 s47, s2, 3
  s_add_u32 s50, s46, s47
  s_lshl_b32 s46, s50, 4
  s_bitcmp0_b32 s50, 0
  s_cselect_b32 s41, 15, -2
  s_cselect_b32 s31, -1, 1
  s_cselect_b32 s40, 15, 0
  s_add_u32 s41, s41, s46
  s_add_u32 s40, s40, s46
  s_mul_i32 s41, s41, 6144
  s_mul_i32 s31, s31, 6144
  s_mul_i32 s40, s40, 6144
  s_mov_b32 s18, 25165824
  s_mov_b32 s19, 0x20000
  s_cmp_lg_u32 s28, 0
  s_cbranch_scc1 L_consumer
  s_mov_b32 s43, s41
  s_mov_b32 s53, 0
  s_lshr_b32 s42, s50, 3
  s_mul_i32 s42, s42, 786432
  s_mov_b32 s45, 0
  s_mov_b32 s4, 0x3e003f
  s_mov_b32 s5, 0xf8
  s_setprio 3
  s_waitcnt lgkmcnt(0)
L_ldk:
  s_bitcmp1_b64 s[4:5], s45
  s_cselect_b64 vcc, -1, 0
  s_max_i32 s44, s43, s42
  s_waitcnt vmcnt(27)
  s_cbranch_vccnz L_w1
  s_waitcnt vmcnt(21)
L_w1:
  s_mov_b32 m0, s53
  s_nop 0
  buffer_load_dwordx4 v1, s[16:19], s44 offen nt lds
  buffer_load_dwordx4 v2, s[16:19], s44 offen offset:1024 nt lds
  buffer_load_dwordx4 v3, s[16:19], s44 offen offset:2048 nt lds
  s_waitcnt vmcnt(27)
  s_cbranch_vccnz L_w2
  s_waitcnt vmcnt(21)
L_w2:
  s_add_u32 m0, s53, 3072
  s_nop 0
  buffer_load_dwordx4 v4, s[16:19], s44 offen nt lds
  buffer_load_dwordx4 v5, s[16:19], s44 offen offset:1024 nt lds
  buffer_load_dwordx4 v6, s[16:19], s44 offen offset:2048 nt lds
  s_add_u32 s43, s43, s31
  s_add_u32 s53, s53, 6144
  s_add_u32 s45, s45, 1
  s_cmp_lt_u32 s45, 18
  s_cbranch_scc1 L_ldk
  v_mov_b32 v26, 0
  v_add_u32 v8, 159744, v8
  s_mov_b64 s[16:17], s[12:13]
  s_mov_b32 s43, s40
  ds_write_b32 v8, v26
  s_waitcnt lgkmcnt(0)
  s_barrier
L_ld:
  s_add_i32 s46, s45, -26
  s_and_b32 s47, s46, 3
  s_lshl_b32 s47, s47, 8
  v_add_u32 v19, s47, v8
  s_ashr_i32 s46, s46, 2
  s_min_i32 s46, s46, 3
L_ld_p:
  ds_read_b32 v27, v19 offset:256
  s_waitcnt lgkmcnt(0)
  v_readfirstlane_b32 s47, v27
  s_cmp_gt_i32 s47, s46
  s_cbranch_scc0 L_ld_p
  s_bitcmp1_b64 s[4:5], s45
  s_cselect_b64 vcc, -1, 0
  s_cselect_b32 s46, 4, 3
  s_sub_u32 s46, s45, s46
  s_max_i32 s44, s43, s42
  v_mov_b32 v26, s46
  s_waitcnt vmcnt(27)
  s_cbranch_vccnz L_w3
  s_waitcnt vmcnt(21)
L_w3:
  s_mov_b32 m0, s53
  s_nop 0
  buffer_load_dwordx4 v1, s[16:19], s44 offen nt lds
  buffer_load_dwordx4 v2, s[16:19], s44 offen offset:1024 nt lds
  buffer_load_dwordx4 v3, s[16:19], s44 offen offset:2048 nt lds
  s_waitcnt vmcnt(27)
  s_cbranch_vccnz L_w4
  s_waitcnt vmcnt(21)
L_w4:
  ds_write_b32 v8, v26
  s_add_u32 m0, s53, 3072
  s_nop 0
  buffer_load_dwordx4 v4, s[16:19], s44 offen nt lds
  buffer_load_dwordx4 v5, s[16:19], s44 offen offset:1024 nt lds
  buffer_load_dwordx4 v6, s[16:19], s44 offen offset:2048 nt lds
  s_add_u32 s43, s43, s31
  s_add_u32 s53, s53, 6144
  s_add_u32 s45, s45, 1
  s_cmp_eq_u32 s45, 26
  s_cselect_b32 s53, 110592, s53
  s_cmp_eq_u32 s45, 34
  s_cselect_b32 s53, 0, s53
  s_cselect_b32 s43, s41, s43
  s_cselect_b64 s[16:17], s[20:21], s[16:17]
  s_cmp_lt_u32 s45, 50
  s_cbranch_scc1 L_ld
L_ldl:
  s_max_i32 s44, s43, s42
  s_mov_b32 m0, s53
  s_nop 0
  buffer_load_dwordx4 v1, s[16:19], s44 offen nt lds
  buffer_load_dwordx4 v2, s[16:19], s44 offen offset:1024 nt lds
  buffer_load_dwordx4 v3, s[16:19], s44 offen offset:2048 nt lds
  s_add_u32 m0, s53, 3072
  s_nop 0
  buffer_load_dwordx4 v4, s[16:19], s44 offen nt lds
  buffer_load_dwordx4 v5, s[16:19], s44 offen offset:1024 nt lds
  buffer_load_dwordx4 v6, s[16:19], s44 offen offset:2048 nt lds
  s_add_u32 s43, s43, s31
  s_add_u32 s53, s53, 6144
  s_cmp_lt_u32 s53, 110592
  s_cbranch_scc1 L_ldl
  v_mov_b32 v30, 47
  s_waitcnt vmcnt(30)
  ds_write_b32 v8, v30
  v_mov_b32 v27, 48
  s_waitcnt vmcnt(24)
  ds_write_b32 v8, v27
  v_mov_b32 v28, 49
  s_waitcnt vmcnt(18)
  ds_write_b32 v8, v28
  v_mov_b32 v29, 50
  s_waitcnt vmcnt(12)
  ds_write_b32 v8, v29
  v_mov_b32 v30, 51
  s_waitcnt vmcnt(6)
  ds_write_b32 v8, v30
  v_mov_b32 v27, 52
  s_waitcnt vmcnt(0)
  ds_write_b32 v8, v27
  s_waitcnt lgkmcnt(0)
  s_endpgm
L_consumer:
  s_mov_b32 s26, 25165824
  s_mov_b32 s27, 0x20000
  v_mov_b32 v17, 0
  v_add_u32 v8, 159744, v8
  s_sub_u32 s52, s28, 1
  ds_write_b32 v8, v17
  s_and_b32 s29, s50, 7
  s_mul_i32 s48, s52, 6144
  s_mul_i32 s46, s52, s31
  s_add_u32 s40, s40, s46
  s_lshl_b32 s31, s31, 2
  s_bitcmp1_b32 s50, 0
  s_cselect_b64 s[56:57], -1, 0
  v_and_b32 v26, 15, v0
  v_lshrrev_b32 v27, 4, v0
  v_and_b32 v28, 7, v0
  v_xor_b32 v28, v28, v27
  v_lshlrev_b32 v28, 4, v28
  v_mul_u32_u24 v29, 384, v26
  v_add3_u32 v11, v28, v29, s48
  v_xor_b32 v12, 64, v11
  v_add_u32 v13, 110592, v11
  v_add_u32 v14, 110592, v12
  v_lshrrev_b32 v28, 2, v0
  v_and_b32 v29, 3, v0
  v_and_b32 v30, 7, v28
  v_xor_b32 v29, v29, v30
  v_lshlrev_b32 v29, 4, v29
  v_mul_u32_u24 v28, 384, v28
  v_add3_u32 v15, v28, v29, s48
  v_xor_b32 v16, 64, v15
  s_add_u32 s48, s48, 135168
  v_add_u32 v7, s48, v7
  v_lshlrev_b32 v27, 2, v27
  v_add_u32 v28, 0, v27
  v_cmp_gt_u32 s[32:33], v28, v26
  v_add_u32 v28, 1, v27
  v_cmp_gt_u32 s[34:35], v28, v26
  v_add_u32 v28, 2, v27
  v_cmp_gt_u32 s[36:37], v28, v26
  v_add_u32 v28, 3, v27
  v_cmp_gt_u32 s[38:39], v28, v26
  v_mov_b32 v28, 0xffff
  v_mov_b32 v29, 0xffff0000
  s_xor_b64 s[32:33], s[32:33], s[56:57]
  s_xor_b64 s[34:35], s[34:35], s[56:57]
  s_xor_b64 s[36:37], s[36:37], s[56:57]
  s_xor_b64 s[38:39], s[38:39], s[56:57]
  v_cndmask_b32 v30, 0, v28, s[32:33]
  v_cndmask_b32 v31, 0, v29, s[34:35]
  v_or_b32 v9, v30, v31
  v_cndmask_b32 v30, 0, v28, s[36:37]
  v_cndmask_b32 v31, 0, v29, s[38:39]
  v_or_b32 v10, v30, v31
  s_mov_b32 s30, 0x3fb8aa3b
  s_mov_b32 s44, 0x3d93cd3a
  v_mov_b32 v19, 159744
  s_mov_b32 s45, 0
  s_mov_b32 s49, 24576
  s_waitcnt lgkmcnt(0)
  s_barrier
L_pk:
  ds_read_b32 v17, v19
  s_waitcnt lgkmcnt(0)
  v_readfirstlane_b32 s55, v17
  s_cmp_gt_u32 s55, 17
  s_cbranch_scc1 L_pk_ok
  s_sleep 1
  s_branch L_pk
L_pk_ok:
L_stepa:
  ds_read_b128 v[104:107], v11 offset:0
  ds_read_b128 v[108:111], v12 offset:0
  ds_read_b128 v[112:115], v11 offset:128
  ds_read_b128 v[116:119], v12 offset:128
  ds_read_b128 v[120:123], v11 offset:256
  ds_read_b128 v[124:127], v12 offset:256
  ds_read_b128 v[128:131], v11 offset:6144
  ds_read_b128 v[132:135], v12 offset:6144
  ds_read_b128 v[136:139], v11 offset:6272
  ds_read_b128 v[140:143], v12 offset:6272
  ds_read_b128 v[144:147], v11 offset:6400
  ds_read_b128 v[148:151], v12 offset:6400
  ds_read_b128 v[152:155], v11 offset:12288
  ds_read_b128 v[156:159], v12 offset:12288
  ds_read_b128 v[160:163], v11 offset:12416
  ds_read_b128 v[164:167], v12 offset:12416
  ds_read_b128 v[168:171], v11 offset:12544
  ds_read_b128 v[172:175], v12 offset:12544
  s_add_u32 s54, s52, 18
  s_add_u32 s45, s45, 1
  v_mov_b32 v18, s45
L_pq:
  ds_read_b32 v17, v19
  s_waitcnt lgkmcnt(0)
  v_readfirstlane_b32 s55, v17
  s_cmp_gt_u32 s55, s54
  s_cbranch_scc1 L_pq_ok
  s_sleep 1
  s_branch L_pq
L_pq_ok:
  ds_read_b128 v[80:83], v13 offset:0
  ds_read_b128 v[84:87], v14 offset:0
  ds_read_b128 v[88:91], v13 offset:128
  ds_read_b128 v[92:95], v14 offset:128
  ds_read_b128 v[96:99], v13 offset:256
  ds_read_b128 v[100:103], v14 offset:256
  ds_write_b32 v8, v18
  s_waitcnt lgkmcnt(6)
  v_mfma_f32_16x16x32_bf16 v[32:35], v[104:107], v[80:83], 0
  v_mfma_f32_16x16x32_bf16 v[36:39], v[128:131], v[80:83], 0
  v_mfma_f32_16x16x32_bf16 v[40:43], v[152:155], v[80:83], 0
  s_waitcnt lgkmcnt(5)
  v_mfma_f32_16x16x32_bf16 v[32:35], v[108:111], v[84:87], v[32:35]
  v_mfma_f32_16x16x32_bf16 v[36:39], v[132:135], v[84:87], v[36:39]
  v_mfma_f32_16x16x32_bf16 v[40:43], v[156:159], v[84:87], v[40:43]
  s_waitcnt lgkmcnt(4)
  v_mfma_f32_16x16x32_bf16 v[32:35], v[112:115], v[88:91], v[32:35]
  v_mfma_f32_16x16x32_bf16 v[36:39], v[136:139], v[88:91], v[36:39]
  v_mfma_f32_16x16x32_bf16 v[40:43], v[160:163], v[88:91], v[40:43]
  s_waitcnt lgkmcnt(3)
  v_mfma_f32_16x16x32_bf16 v[32:35], v[116:119], v[92:95], v[32:35]
  v_mfma_f32_16x16x32_bf16 v[36:39], v[140:143], v[92:95], v[36:39]
  v_mfma_f32_16x16x32_bf16 v[40:43], v[164:167], v[92:95], v[40:43]
  s_waitcnt lgkmcnt(2)
  v_mfma_f32_16x16x32_bf16 v[32:35], v[120:123], v[96:99], v[32:35]
  v_mfma_f32_16x16x32_bf16 v[36:39], v[144:147], v[96:99], v[36:39]
  v_mfma_f32_16x16x32_bf16 v[40:43], v[168:171], v[96:99], v[40:43]
  s_waitcnt lgkmcnt(1)
  v_mfma_f32_16x16x32_bf16 v[32:35], v[124:127], v[100:103], v[32:35]
  v_mfma_f32_16x16x32_bf16 v[36:39], v[148:151], v[100:103], v[36:39]
  v_mfma_f32_16x16x32_bf16 v[40:43], v[172:175], v[100:103], v[40:43]
  v_add_u32 v11, 24576, v11
  v_add_u32 v12, 24576, v12
  v_add_u32 v13, s49, v13
  v_add_u32 v14, s49, v14
  s_sub_u32 s49, 0, s49
  s_cmp_lg_u32 s29, 0
  s_cselect_b32 s46, 0, s52
  s_cmp_lt_u32 s46, 14
  s_cbranch_scc1 L_nohs
  v_mov_b32 v40, 0xff800000
  v_mov_b32 v41, 0xff800000
  v_mov_b32 v42, 0xff800000
  v_mov_b32 v43, 0xff800000
  s_cmp_lt_u32 s52, 15
  s_cbranch_scc1 L_nohs
  v_mov_b32 v36, 0xff800000
  v_mov_b32 v37, 0xff800000
  v_mov_b32 v38, 0xff800000
  v_mov_b32 v39, 0xff800000
L_nohs:
  v_cndmask_b32 v32, v32, v40, s[32:33]
  v_cndmask_b32 v33, v33, v41, s[34:35]
  v_cndmask_b32 v34, v34, v42, s[36:37]
  v_cndmask_b32 v35, v35, v43, s[38:39]
  v_cvt_pk_bf16_f32 v44, v32, v33
  v_cvt_pk_bf16_f32 v45, v34, v35
  v_cvt_pk_bf16_f32 v46, v36, v37
  v_cvt_pk_bf16_f32 v47, v38, v39
  v_lshlrev_b32 v32, 16, v44
  v_and_b32 v33, 0xffff0000, v44
  v_lshlrev_b32 v34, 16, v45
  v_and_b32 v35, 0xffff0000, v45
  v_lshlrev_b32 v36, 16, v46
  v_and_b32 v37, 0xffff0000, v46
  v_lshlrev_b32 v38, 16, v47
  v_and_b32 v39, 0xffff0000, v47
  v_mul_f32 v32, s44, v32
  v_mul_f32 v33, s44, v33
  v_mul_f32 v34, s44, v34
  v_mul_f32 v35, s44, v35
  v_mul_f32 v36, s44, v36
  v_mul_f32 v37, s44, v37
  v_mul_f32 v38, s44, v38
  v_mul_f32 v39, s44, v39
  v_cvt_pk_bf16_f32 v44, v32, v33
  v_cvt_pk_bf16_f32 v45, v34, v35
  v_cvt_pk_bf16_f32 v46, v36, v37
  v_cvt_pk_bf16_f32 v47, v38, v39
  v_lshlrev_b32 v32, 16, v44
  v_and_b32 v33, 0xffff0000, v44
  v_lshlrev_b32 v34, 16, v45
  v_and_b32 v35, 0xffff0000, v45
  v_lshlrev_b32 v36, 16, v46
  v_and_b32 v37, 0xffff0000, v46
  v_lshlrev_b32 v38, 16, v47
  v_and_b32 v39, 0xffff0000, v47
  v_max3_f32 v17, v36, v37, v38
  v_max3_f32 v18, v32, v33, v39
  v_max3_f32 v17, v17, v34, v35
  v_max_f32 v17, v17, v18
  v_mov_b32 v18, v17
  s_nop 1
  v_permlane16_swap_b32 v17, v18
  v_max_f32 v17, v17, v18
  v_mov_b32 v18, v17
  s_nop 1
  v_permlane32_swap_b32 v17, v18
  v_max_f32 v17, v17, v18
  v_sub_f32 v44, v32, v17
  v_sub_f32 v45, v33, v17
  v_sub_f32 v46, v34, v17
  v_sub_f32 v47, v35, v17
  v_sub_f32 v48, v36, v17
  v_sub_f32 v49, v37, v17
  v_sub_f32 v50, v38, v17
  v_sub_f32 v51, v39, v17
  v_mul_f32 v44, s30, v44
  v_mul_f32 v45, s30, v45
  v_mul_f32 v46, s30, v46
  v_mul_f32 v47, s30, v47
  v_mul_f32 v48, s30, v48
  v_mul_f32 v49, s30, v49
  v_mul_f32 v50, s30, v50
  v_mul_f32 v51, s30, v51
  v_exp_f32 v44, v44
  v_exp_f32 v45, v45
  v_exp_f32 v46, v46
  v_exp_f32 v47, v47
  v_exp_f32 v48, v48
  v_exp_f32 v49, v49
  v_exp_f32 v50, v50
  v_exp_f32 v51, v51
  v_add_f32 v17, v44, v45
  v_add_f32 v18, v46, v47
  v_add_f32 v17, v17, v48
  v_add_f32 v18, v18, v49
  v_add_f32 v17, v17, v50
  v_add_f32 v18, v18, v51
  v_add_f32 v17, v17, v18
  v_mov_b32 v18, v17
  s_nop 1
  v_permlane16_swap_b32 v17, v18
  v_add_f32 v17, v17, v18
  v_mov_b32 v18, v17
  s_nop 1
  v_permlane32_swap_b32 v17, v18
  v_add_f32 v17, v17, v18
  v_rcp_f32 v17, v17
  s_add_u32 s52, s52, 4
  v_mul_f32 v44, v44, v17
  v_mul_f32 v45, v45, v17
  v_mul_f32 v46, v46, v17
  v_mul_f32 v47, v47, v17
  v_mul_f32 v48, v48, v17
  v_mul_f32 v49, v49, v17
  v_mul_f32 v50, v50, v17
  v_mul_f32 v51, v51, v17
  v_cvt_pk_bf16_f32 v20, v44, v45
  v_cvt_pk_bf16_f32 v21, v46, v47
  v_cvt_pk_bf16_f32 v22, v48, v49
  v_cvt_pk_bf16_f32 v23, v50, v51
  s_cmp_lg_u32 s45, 1
  s_cbranch_scc1 L_sp1
  v_accvgpr_write_b32 a0, v20
  v_accvgpr_write_b32 a1, v21
  v_accvgpr_write_b32 a2, v22
  v_accvgpr_write_b32 a3, v23
  s_branch L_stepa
L_sp1:
  s_cmp_lg_u32 s45, 2
  s_cbranch_scc1 L_sp2
  v_accvgpr_write_b32 a24, v20
  v_accvgpr_write_b32 a25, v21
  v_accvgpr_write_b32 a26, v22
  v_accvgpr_write_b32 a27, v23
  s_branch L_stepa
L_sp2:
  s_cmp_lg_u32 s45, 3
  s_cbranch_scc1 L_sp3
  v_accvgpr_write_b32 a48, v20
  v_accvgpr_write_b32 a49, v21
  v_accvgpr_write_b32 a50, v22
  v_accvgpr_write_b32 a51, v23
  s_branch L_stepa
L_sp3:
  v_accvgpr_write_b32 a72, v20
  v_accvgpr_write_b32 a73, v21
  v_accvgpr_write_b32 a74, v22
  v_accvgpr_write_b32 a75, v23
  v_add_u32 v13, 24576, v13
  v_add_u32 v14, 24576, v14
  s_add_u32 s54, s52, 19
  s_mov_b32 s45, 0
  v_accvgpr_read_b32 v20, a0
  v_accvgpr_read_b32 v21, a1
  v_accvgpr_read_b32 v22, a2
  v_accvgpr_read_b32 v23, a3
L_stepb:
  v_and_b32 v24, v20, v9
  v_and_b32 v25, v21, v10
  v_xor_b32 v20, v20, v24
  v_xor_b32 v21, v21, v25
  s_cmp_gt_u32 s55, s54
  s_cbranch_scc1 L_pm_ok
L_pm:
  ds_read_b32 v17, v19
  s_waitcnt lgkmcnt(0)
  v_readfirstlane_b32 s55, v17
  s_cmp_gt_u32 s55, s54
  s_cbranch_scc1 L_pm_ok
  s_sleep 1
  s_branch L_pm
L_pm_ok:
  s_waitcnt lgkmcnt(0)
  ds_read_b64_tr_b16 v[104:105], v15 offset:0
  ds_read_b64_tr_b16 v[106:107], v15 offset:6144
  ds_read_b64_tr_b16 v[108:109], v15 offset:8
  ds_read_b64_tr_b16 v[110:111], v15 offset:6152
  ds_read_b64_tr_b16 v[112:113], v16 offset:0
  ds_read_b64_tr_b16 v[114:115], v16 offset:6144
  ds_read_b64_tr_b16 v[116:117], v16 offset:8
  ds_read_b64_tr_b16 v[118:119], v16 offset:6152
  ds_read_b64_tr_b16 v[120:121], v15 offset:128
  ds_read_b64_tr_b16 v[122:123], v15 offset:6272
  ds_read_b64_tr_b16 v[124:125], v15 offset:136
  ds_read_b64_tr_b16 v[126:127], v15 offset:6280
  s_waitcnt lgkmcnt(10)
  v_mfma_f32_16x16x32_bf16 v[32:35], v[104:107], v[20:23], 0
  ds_read_b64_tr_b16 v[128:129], v16 offset:128
  ds_read_b64_tr_b16 v[130:131], v16 offset:6272
  s_waitcnt lgkmcnt(10)
  v_mfma_f32_16x16x32_bf16 v[36:39], v[108:111], v[20:23], 0
  ds_read_b64_tr_b16 v[132:133], v16 offset:136
  ds_read_b64_tr_b16 v[134:135], v16 offset:6280
  s_waitcnt lgkmcnt(10)
  v_mfma_f32_16x16x32_bf16 v[40:43], v[112:115], v[20:23], 0
  ds_read_b64_tr_b16 v[136:137], v15 offset:256
  ds_read_b64_tr_b16 v[138:139], v15 offset:6400
  s_waitcnt lgkmcnt(10)
  v_mfma_f32_16x16x32_bf16 v[44:47], v[116:119], v[20:23], 0
  ds_read_b64_tr_b16 v[140:141], v15 offset:264
  ds_read_b64_tr_b16 v[142:143], v15 offset:6408
  s_waitcnt lgkmcnt(10)
  v_mfma_f32_16x16x32_bf16 v[48:51], v[120:123], v[20:23], 0
  ds_read_b64_tr_b16 v[144:145], v16 offset:256
  ds_read_b64_tr_b16 v[146:147], v16 offset:6400
  s_waitcnt lgkmcnt(10)
  v_mfma_f32_16x16x32_bf16 v[52:55], v[124:127], v[20:23], 0
  ds_read_b64_tr_b16 v[148:149], v16 offset:264
  ds_read_b64_tr_b16 v[150:151], v16 offset:6408
  s_waitcnt lgkmcnt(10)
  v_mfma_f32_16x16x32_bf16 v[56:59], v[128:131], v[20:23], 0
  s_waitcnt lgkmcnt(8)
  v_mfma_f32_16x16x32_bf16 v[60:63], v[132:135], v[20:23], 0
  s_waitcnt lgkmcnt(6)
  v_mfma_f32_16x16x32_bf16 v[64:67], v[136:139], v[20:23], 0
  s_waitcnt lgkmcnt(4)
  v_mfma_f32_16x16x32_bf16 v[68:71], v[140:143], v[20:23], 0
  s_waitcnt lgkmcnt(2)
  v_mfma_f32_16x16x32_bf16 v[72:75], v[144:147], v[20:23], 0
  s_waitcnt lgkmcnt(0)
  v_mfma_f32_16x16x32_bf16 v[76:79], v[148:151], v[20:23], 0
  s_add_u32 s45, s45, 1
  s_add_u32 s54, s54, 1
  s_cmp_gt_u32 s55, s54
  s_cbranch_scc1 L_pb_ok
L_pb:
  ds_read_b32 v17, v19
  s_waitcnt lgkmcnt(0)
  v_readfirstlane_b32 s55, v17
  s_cmp_gt_u32 s55, s54
  s_cbranch_scc1 L_pb_ok
  s_sleep 1
  s_branch L_pb
L_pb_ok:
  ds_read_b64_tr_b16 v[80:81], v15 offset:12288
  ds_read_b64_tr_b16 v[82:83], v15 offset:12296
  ds_read_b64_tr_b16 v[84:85], v16 offset:12288
  ds_read_b64_tr_b16 v[86:87], v16 offset:12296
  ds_read_b64_tr_b16 v[88:89], v15 offset:12416
  ds_read_b64_tr_b16 v[90:91], v15 offset:12424
  ds_read_b64_tr_b16 v[92:93], v16 offset:12416
  ds_read_b64_tr_b16 v[94:95], v16 offset:12424
  ds_read_b64_tr_b16 v[96:97], v15 offset:12544
  ds_read_b64_tr_b16 v[98:99], v15 offset:12552
  ds_read_b64_tr_b16 v[100:101], v16 offset:12544
  ds_read_b64_tr_b16 v[102:103], v16 offset:12552
  s_waitcnt lgkmcnt(11)
  v_mfma_f32_16x16x16_bf16 v[32:35], v[80:81], v[24:25], v[32:35]
  s_waitcnt lgkmcnt(10)
  v_mfma_f32_16x16x16_bf16 v[36:39], v[82:83], v[24:25], v[36:39]
  s_waitcnt lgkmcnt(9)
  v_mfma_f32_16x16x16_bf16 v[40:43], v[84:85], v[24:25], v[40:43]
  s_waitcnt lgkmcnt(8)
  v_mfma_f32_16x16x16_bf16 v[44:47], v[86:87], v[24:25], v[44:47]
  s_waitcnt lgkmcnt(7)
  v_mfma_f32_16x16x16_bf16 v[48:51], v[88:89], v[24:25], v[48:51]
  v_cvt_pk_bf16_f32 v152, v32, v33
  v_cvt_pk_bf16_f32 v153, v34, v35
  s_waitcnt lgkmcnt(6)
  v_mfma_f32_16x16x16_bf16 v[52:55], v[90:91], v[24:25], v[52:55]
  v_cvt_pk_bf16_f32 v154, v36, v37
  v_cvt_pk_bf16_f32 v155, v38, v39
  s_waitcnt lgkmcnt(5)
  v_mfma_f32_16x16x16_bf16 v[56:59], v[92:93], v[24:25], v[56:59]
  v_cvt_pk_bf16_f32 v156, v40, v41
  v_cvt_pk_bf16_f32 v157, v42, v43
  s_waitcnt lgkmcnt(4)
  v_mfma_f32_16x16x16_bf16 v[60:63], v[94:95], v[24:25], v[60:63]
  v_cvt_pk_bf16_f32 v158, v44, v45
  v_cvt_pk_bf16_f32 v159, v46, v47
  s_waitcnt lgkmcnt(3)
  v_mfma_f32_16x16x16_bf16 v[64:67], v[96:97], v[24:25], v[64:67]
  v_cvt_pk_bf16_f32 v160, v48, v49
  v_cvt_pk_bf16_f32 v161, v50, v51
  s_waitcnt lgkmcnt(2)
  v_mfma_f32_16x16x16_bf16 v[68:71], v[98:99], v[24:25], v[68:71]
  v_cvt_pk_bf16_f32 v162, v52, v53
  v_cvt_pk_bf16_f32 v163, v54, v55
  s_waitcnt lgkmcnt(1)
  v_mfma_f32_16x16x16_bf16 v[72:75], v[100:101], v[24:25], v[72:75]
  v_cvt_pk_bf16_f32 v164, v56, v57
  v_cvt_pk_bf16_f32 v165, v58, v59
  s_waitcnt lgkmcnt(0)
  v_mfma_f32_16x16x16_bf16 v[76:79], v[102:103], v[24:25], v[76:79]
  v_cvt_pk_bf16_f32 v166, v60, v61
  v_cvt_pk_bf16_f32 v167, v62, v63
  ds_write_b128 v13, v[152:155] offset:0
  ds_write_b128 v14, v[156:159] offset:0
  ds_write_b128 v13, v[160:163] offset:128
  ds_write_b128 v14, v[164:167] offset:128
  v_cvt_pk_bf16_f32 v168, v64, v65
  v_cvt_pk_bf16_f32 v169, v66, v67
  v_cvt_pk_bf16_f32 v170, v68, v69
  v_cvt_pk_bf16_f32 v171, v70, v71
  ds_write_b128 v13, v[168:171] offset:256
  v_cvt_pk_bf16_f32 v172, v72, v73
  v_cvt_pk_bf16_f32 v173, v74, v75
  v_cvt_pk_bf16_f32 v174, v76, v77
  v_cvt_pk_bf16_f32 v175, v78, v79
  ds_write_b128 v14, v[172:175] offset:256
  v_add_u32 v15, 24576, v15
  v_add_u32 v16, 24576, v16
  s_add_u32 s54, s54, 3
  s_cmp_lg_u32 s45, 1
  s_cbranch_scc1 L_rb1
  ds_read_b128 a[0:3], v7 offset:0
  ds_read_b128 a[4:7], v7 offset:1024
  ds_read_b128 a[8:11], v7 offset:2048
  ds_read_b128 a[12:15], v7 offset:3072
  ds_read_b128 a[16:19], v7 offset:4096
  ds_read_b128 a[20:23], v7 offset:5120
  v_accvgpr_read_b32 v20, a24
  v_accvgpr_read_b32 v21, a25
  v_accvgpr_read_b32 v22, a26
  v_accvgpr_read_b32 v23, a27
  s_branch L_stepb
L_rb1:
  s_cmp_lg_u32 s45, 2
  s_cbranch_scc1 L_rb2
  ds_read_b128 a[24:27], v7 offset:0
  ds_read_b128 a[28:31], v7 offset:1024
  ds_read_b128 a[32:35], v7 offset:2048
  ds_read_b128 a[36:39], v7 offset:3072
  ds_read_b128 a[40:43], v7 offset:4096
  ds_read_b128 a[44:47], v7 offset:5120
  v_accvgpr_read_b32 v20, a48
  v_accvgpr_read_b32 v21, a49
  v_accvgpr_read_b32 v22, a50
  v_accvgpr_read_b32 v23, a51
  s_branch L_stepb
L_rb2:
  s_cmp_lg_u32 s45, 3
  s_cbranch_scc1 L_rb3
  ds_read_b128 a[48:51], v7 offset:0
  ds_read_b128 a[52:55], v7 offset:1024
  ds_read_b128 a[56:59], v7 offset:2048
  ds_read_b128 a[60:63], v7 offset:3072
  ds_read_b128 a[64:67], v7 offset:4096
  ds_read_b128 a[68:71], v7 offset:5120
  v_accvgpr_read_b32 v20, a72
  v_accvgpr_read_b32 v21, a73
  v_accvgpr_read_b32 v22, a74
  v_accvgpr_read_b32 v23, a75
  s_branch L_stepb
L_rb3:
  ds_read_b128 v[104:107], v7 offset:0
  ds_read_b128 v[108:111], v7 offset:1024
  ds_read_b128 v[112:115], v7 offset:2048
  ds_read_b128 v[116:119], v7 offset:3072
  ds_read_b128 v[120:123], v7 offset:4096
  ds_read_b128 v[124:127], v7 offset:5120
  s_cmp_gt_u32 s55, 51
  s_cbranch_scc1 L_pw_ok
L_pw:
  ds_read_b32 v17, v19
  s_waitcnt lgkmcnt(0)
  v_readfirstlane_b32 s55, v17
  s_cmp_gt_u32 s55, 51
  s_cbranch_scc1 L_pw_ok
  s_sleep 1
  s_branch L_pw
L_pw_ok:
  buffer_store_dwordx4 a[0:3], v1, s[24:27], s40 offen sc1
  buffer_store_dwordx4 a[4:7], v2, s[24:27], s40 offen offset:1024 sc1
  buffer_store_dwordx4 a[8:11], v3, s[24:27], s40 offen offset:2048 sc1
  buffer_store_dwordx4 a[12:15], v4, s[24:27], s40 offen sc1
  buffer_store_dwordx4 a[16:19], v5, s[24:27], s40 offen offset:1024 sc1
  buffer_store_dwordx4 a[20:23], v6, s[24:27], s40 offen offset:2048 sc1
  s_add_u32 s40, s40, s31
  buffer_store_dwordx4 a[24:27], v1, s[24:27], s40 offen sc1
  buffer_store_dwordx4 a[28:31], v2, s[24:27], s40 offen offset:1024 sc1
  buffer_store_dwordx4 a[32:35], v3, s[24:27], s40 offen offset:2048 sc1
  buffer_store_dwordx4 a[36:39], v4, s[24:27], s40 offen sc1
  buffer_store_dwordx4 a[40:43], v5, s[24:27], s40 offen offset:1024 sc1
  buffer_store_dwordx4 a[44:47], v6, s[24:27], s40 offen offset:2048 sc1
  s_add_u32 s40, s40, s31
  buffer_store_dwordx4 a[48:51], v1, s[24:27], s40 offen sc1
  buffer_store_dwordx4 a[52:55], v2, s[24:27], s40 offen offset:1024 sc1
  buffer_store_dwordx4 a[56:59], v3, s[24:27], s40 offen offset:2048 sc1
  buffer_store_dwordx4 a[60:63], v4, s[24:27], s40 offen sc1
  buffer_store_dwordx4 a[64:67], v5, s[24:27], s40 offen offset:1024 sc1
  buffer_store_dwordx4 a[68:71], v6, s[24:27], s40 offen offset:2048 sc1
  s_add_u32 s40, s40, s31
  s_waitcnt lgkmcnt(0)
  buffer_store_dwordx4 v[104:107], v1, s[24:27], s40 offen sc1
  buffer_store_dwordx4 v[108:111], v2, s[24:27], s40 offen offset:1024 sc1
  buffer_store_dwordx4 v[112:115], v3, s[24:27], s40 offen offset:2048 sc1
  buffer_store_dwordx4 v[116:119], v4, s[24:27], s40 offen sc1
  buffer_store_dwordx4 v[120:123], v5, s[24:27], s40 offen offset:1024 sc1
  buffer_store_dwordx4 v[124:127], v6, s[24:27], s40 offen offset:2048 sc1
L_end:
  s_endpgm
.section .rodata,"a"
.p2align 6
.amdhsa_kernel standalone__sliding_local_fixed_window__prompt_kernel
  .amdhsa_next_free_vgpr 252
  .amdhsa_next_free_sgpr 60
  .amdhsa_accum_offset 176
  .amdhsa_group_segment_fixed_size 0
  .amdhsa_kernarg_size 48
  .amdhsa_user_sgpr_count 2
  .amdhsa_user_sgpr_kernarg_segment_ptr 1
  .amdhsa_system_sgpr_workgroup_id_x 1
  .amdhsa_float_denorm_mode_32 3
.end_amdhsa_kernel
```
